```python
import torch

def _softmax(x, axis=-1):
    return torch.softmax(x, dim=axis)
def _gelu(x):
    return torch.nn.functional.gelu(x, approximate="tanh")
def _silu(x):
    return torch.nn.functional.silu(x)
def _sigmoid(x):
    return torch.sigmoid(x)
def _layernorm(x, axis=-1, eps=1e-5):
    m = x.mean(dim=axis, keepdim=True)
    v = x.var(dim=axis, keepdim=True, unbiased=False)
    return (x - m) / torch.sqrt(v + eps)
def _scatter_add(tgt, idx, src, axis=0):
    return tgt.clone().index_add_(axis, idx, src)
def _segment_sum(src, seg, n):
    out = torch.zeros((n,) + src.shape[1:], dtype=src.dtype)
    return out.index_add_(0, seg, src)
def _pad(x, pw):
    flat = tuple(v for pair in reversed(pw) for v in pair)
    return torch.nn.functional.pad(x, flat)

kernel_name = 'gated_mix__sliding_block_cached__glu_gated_swiglu__decode'

def setup_inputs():

    _w = (lambda a: (lambda t: t.to(torch.bfloat16) if t.is_floating_point() else t)(torch.as_tensor(a)))
    def _A_setup():
        B, Sq, D = 1, 1, 640
        Hq, Hkv, Sk, Dh = 32, 32, 32768, 192
        assert Hq % Hkv == 0, (Hq, Hkv)
        return {
            "x": _w((lambda *s: torch.randn(*s, dtype=torch.bfloat16) * 0.05)(B, Sq, D)),
            "k_cache": _w((lambda *s: torch.randn(*s, dtype=torch.bfloat16) * 6.4)(B, Hkv, Sk, Dh)),
            "v_cache": _w((lambda *s: torch.randn(*s, dtype=torch.bfloat16) * 0.05)(B, Hkv, Sk, Dh)),
            "wq": _w((lambda *s: torch.randn(*s, dtype=torch.bfloat16) * 3.2)(D, Hq * Dh) * (D ** -0.5)),
            "wo": _w((lambda *s: torch.randn(*s, dtype=torch.bfloat16) * 0.05)(Hq * Dh, D) * ((Hq * Dh) ** -0.5)),
        }
    _A_in = _A_setup()

    def _B_setup():
        B, S, D, F = 1, 1, 640, 1536
        return {
            "x": _w((lambda *s: torch.randn(*s, dtype=torch.bfloat16) * 0.05)(B, S, D)),
            "w1": _w((lambda *s: torch.randn(*s, dtype=torch.bfloat16) * 0.4)(D, F) * (2.0 / D) ** 0.5),
            "w3": _w((lambda *s: torch.randn(*s, dtype=torch.bfloat16) * 0.4)(D, F) * (2.0 / D) ** 0.5),
            "w2": _w((lambda *s: torch.randn(*s, dtype=torch.bfloat16) * 0.4)(F, D) * (2.0 / F) ** 0.5),
        }
    _B_in = _B_setup()

    return {
        "A_x": _A_in["x"],
        "A_k_cache": _A_in["k_cache"],
        "A_v_cache": _A_in["v_cache"],
        "A_wq": _A_in["wq"],
        "A_wo": _A_in["wo"],
        "B_x": _B_in["x"],
        "B_w1": _B_in["w1"],
        "B_w3": _B_in["w3"],
        "B_w2": _B_in["w2"],
        "gate_w": _w((lambda *s: torch.randn(*s, dtype=torch.bfloat16) * 0.1)(640) * 16.0),
    }

def reference(A_x, A_k_cache, A_v_cache, A_wq, A_wo, B_x, B_w1, B_w3, B_w2, gate_w):
    def _A_ref(x, k_cache, v_cache, wq, wo):
        B, Sq, D = x.shape
        Hq, Dh = 32, 192
        Hkv, Sk = k_cache.shape[1], k_cache.shape[2]
        W = min(4096, max(256, Sk // 4))
        rep = Hq // Hkv
        q = (lambda x, *d: x.permute(*d))((x @ wq).reshape(B, Sq, Hq, Dh), 0, 2, 1, 3)
        k = (lambda x, n, axis: torch.repeat_interleave(x, n, dim=axis))(k_cache[:, :, Sk - W:, :], rep, axis=1)
        v = (lambda x, n, axis: torch.repeat_interleave(x, n, dim=axis))(v_cache[:, :, Sk - W:, :], rep, axis=1)
        scores = torch.einsum("bhqd,bhkd->bhqk", q, k) * (Dh ** -0.5)
        p = _softmax(scores, axis=-1)
        o = torch.einsum("bhqk,bhkd->bhqd", p, v)
        return (lambda x, *d: x.permute(*d))(o, 0, 2, 1, 3).reshape(B, Sq, Hq * Dh) @ wo

    def _B_ref(x, w1, w3, w2):
        gate = torch.einsum("bsd,df->bsf", x, w1)
        up = torch.einsum("bsd,df->bsf", x, w3)
        h = _silu(gate) * up
        out = torch.einsum("bsf,fd->bsd", h, w2)
        return out

    x = A_x
    g = _sigmoid((x * gate_w).sum(-1, keepdims=True))
    a = _A_ref(x, A_k_cache, A_v_cache, A_wq, A_wo)
    b = _B_ref(x, B_w1, B_w3, B_w2)
    return g * a + (1 - g) * b
```

```asm
; @launch grid=(256,1,1) block=(1024,1,1) lds=27520
.amdgcn_target "amdgcn-amd-amdhsa--gfx950"
.text
.globl gated_mix__sliding_block_cached__glu_gated_swiglu__decode_kernel
.p2align 8
.type gated_mix__sliding_block_cached__glu_gated_swiglu__decode_kernel,@function
gated_mix__sliding_block_cached__glu_gated_swiglu__decode_kernel:
    s_load_dwordx2 s[60:61], s[0:1], 8
    s_mul_i32 s39, s2, 257
    s_cmpk_ge_u32 s2, 256
    s_cbranch_scc1 L_exit
    s_bfe_u32 s30, s39, 0x50006
    s_xor_b32 s30, s30, 2
    s_mul_i32 s37, s30, 136
    s_and_b32 s36, s2, 32
    s_add_u32 s37, s37, s36
    s_bfe_u32 s36, s2, 0x20003
    s_add_u32 s37, s37, s36
    v_bfe_u32 v1, v0, 3, 3
    v_and_b32 v3, 0x3c0, v0
    v_and_b32 v2, 7, v0
    v_cmp_lt_u32 vcc, 0x1ff, v0
    s_lshl_b32 s74, s30, 15
    s_addk_i32 s74, 28672
    v_lshl_add_u32 v3, v1, 2, v3
    v_add_u32 v3, s37, v3
    s_cbranch_vccnz L_Astart
    v_bfe_u32 v124, v3, 0, 12
    v_or_b32 v124, s74, v124
    v_mul_u32_u24 v124, 384, v124
    v_lshl_add_u32 v124, v2, 4, v124
    s_waitcnt lgkmcnt(0)
    global_load_dwordx4 v[28:31], v124, s[60:61] offset:0 nt
    global_load_dwordx4 v[32:35], v124, s[60:61] offset:128 nt
    global_load_dwordx4 v[36:39], v124, s[60:61] offset:256 nt
    s_branch L_Bgo
L_Astart:
    s_load_dwordx16 s[4:19], s[0:1], 0
    s_load_dwordx8 s[20:27], s[0:1], 64
    s_load_dwordx2 s[28:29], s[0:1], 96
    v_bfe_u32 v1, v0, 6, 3
    v_and_b32 v0, 63, v0
    v_readfirstlane_b32 s3, v1
    v_lshrrev_b32 v1, 3, v0
    s_bfe_u32 s39, s39, 0x80003
    s_and_b32 s31, s39, 7
    s_lshr_b32 s38, s2, 3
    s_mul_i32 s37, s38, 26
    s_lshr_b32 s37, s37, 8
    s_and_b32 s33, s2, 7
    s_mul_i32 s33, s33, 3
    s_add_u32 s33, s33, s37
    s_mul_i32 s37, s37, 10
    s_sub_u32 s34, s38, s37
    s_mul_i32 s32, s39, 1664
    s_mov_b32 s35, 0x200000
    v_mov_b32 v5, 0
    s_cmp_lg_u32 s3, 0
    s_cbranch_scc1 L_not0
    s_setprio 3
    v_mov_b32 v12, -1
    v_mov_b32 v13, -1
    v_mov_b32 v14, -1
    v_mov_b32 v15, -1
    v_lshl_add_u32 v124, v0, 4, s32
    s_xor_b32 s36, s39, 16
    s_mul_i32 s36, s36, 768
    s_add_u32 s36, s36, 424704
    s_mov_b64 vcc, 0xffff
    v_lshl_add_u32 v125, v0, 4, s36
    v_cndmask_b32 v125, v125, v124, vcc
    v_lshl_add_u32 v126, v2, 4, s32
    s_waitcnt lgkmcnt(0)
    global_store_dwordx4 v124, v[12:15], s[28:29]
    global_store_dwordx4 v125, v[12:15], s[28:29] offset:1024
    global_store_dwordx4 v126, v[12:15], s[28:29] offset:1280
    s_cmpk_lt_u32 s2, 240
    s_cbranch_scc1 L_w0b
    s_mul_i32 s36, s2, 2944
    s_add_u32 s36, s36, -14848
    v_lshl_add_u32 v127, v0, 4, s36
    s_lshl_b32 s36, s2, 9
    s_add_u32 s36, s36, 561152
    s_mov_b32 exec_hi, 0
    v_lshl_add_u32 v127, v0, 4, s36
    s_mov_b32 exec_hi, -1
    global_store_dwordx4 v127, v[12:15], s[28:29] sc1
    s_branch L_w0b
L_not0:
    s_cmp_ge_u32 s3, 6
    s_cbranch_scc1 L_w67
    s_mov_b32 s51, 0x20000
    s_cmp_ge_u32 s3, 4
    s_cbranch_scc1 L_Wffn
    s_mov_b32 s50, 7864320
    s_movk_i32 s53, 12288
    s_mul_i32 s36, s31, 983040
    s_mul_i32 s37, s30, 384
    s_add_u32 s36, s36, s37
    s_sub_u32 s38, s3, 1
    s_lshl_b32 s37, s38, 7
    s_add_u32 s64, s36, s37
    v_mul_u32_u24 v124, 122880, v1
    s_mul_i32 s36, s31, 160
    v_mul_u32_u24 v125, 20, v1
    s_branch L_Wgo
L_Wffn:
    s_cmpk_ge_u32 s2, 240
    s_cbranch_scc1 L_w7
    s_mov_b32 s50, 1966080
    s_movk_i32 s53, 3072
    s_mul_i32 s64, s34, 196608
    s_lshl_b32 s37, s33, 7
    s_add_u32 s64, s64, s37
    v_mul_u32_u24 v124, 24576, v1
    s_lshl_b32 s36, s34, 7
    v_lshlrev_b32 v125, 4, v1
L_Wgo:
    v_add_u32 v125, s36, v125
    v_lshl_add_u32 v124, v2, 4, v124
    v_min_u32 v126, 1260, v125
    s_add_u32 s65, s64, s53
    s_add_u32 s66, s65, s53
    s_add_u32 s67, s66, s53
    s_add_u32 s68, s67, s53
    s_add_u32 s69, s68, s53
    s_add_u32 s70, s69, s53
    s_add_u32 s71, s70, s53
    s_add_u32 s72, s71, s53
    s_add_u32 s73, s72, s53
    s_waitcnt lgkmcnt(0)
    s_cmp_eq_u32 s3, 4
    s_cselect_b64 s[48:49], s[16:17], s[18:19]
    s_cmp_lt_u32 s3, 4
    s_cselect_b64 s[48:49], s[10:11], s[48:49]
    buffer_load_dwordx4 v[28:31], v124, s[48:51], s64 offen nt
    buffer_load_dwordx4 v[32:35], v124, s[48:51], s65 offen nt
    buffer_load_dwordx4 v[36:39], v124, s[48:51], s66 offen nt
    buffer_load_dwordx4 v[40:43], v124, s[48:51], s67 offen nt
    buffer_load_dwordx4 v[44:47], v124, s[48:51], s68 offen nt
    buffer_load_dwordx4 v[48:51], v124, s[48:51], s69 offen nt
    buffer_load_dwordx4 v[52:55], v124, s[48:51], s70 offen nt
    buffer_load_dwordx4 v[56:59], v124, s[48:51], s71 offen nt
    global_load_dwordx4 v[16:19], v125, s[4:5]
    global_load_dword v20, v126, s[4:5] offset:16
    s_cbranch_scc0 L_W8
    buffer_load_dwordx4 v[60:63], v124, s[48:51], s72 offen nt
    buffer_load_dwordx4 v[64:67], v124, s[48:51], s73 offen nt
L_W8:
    s_barrier
    v_and_b32 v6, 1, v0
    v_lshlrev_b32 v6, 4, v6
    v_mov_b32 v7, 0xffff
    v_lshlrev_b32 v6, v6, v7
    v_lshrrev_b32 v7, 1, v2
    v_cmp_eq_u32 s[40:41], 0, v7
    v_cmp_eq_u32 s[42:43], 1, v7
    v_cmp_eq_u32 s[44:45], 2, v7
    v_cmp_eq_u32 s[46:47], 3, v7
    v_cndmask_b32 v8, 0, v6, s[40:41]
    v_cndmask_b32 v9, 0, v6, s[42:43]
    v_cndmask_b32 v10, 0, v6, s[44:45]
    v_cndmask_b32 v11, 0, v6, s[46:47]
    s_lshl_b32 s37, s3, 8
    s_add_u32 s37, s37, s32
    s_mov_b32 s54, 0x01000100
    s_mov_b32 s55, 0x03020302
    v_lshl_add_u32 v124, v2, 5, s37
    v_and_b32 v6, 16, v0
    v_add_u32 v124, v124, v6
    v_lshrrev_b32 v6, 5, v0
    v_lshl_add_u32 v124, v6, 3, v124
    s_cmp_ge_u32 s3, 4
    s_waitcnt vmcnt(0)
    v_perm_b32 v6, v16, v16, s54
    v_and_b32 v76, v6, v8
    v_and_b32 v77, v6, v9
    v_and_b32 v78, v6, v10
    v_and_b32 v79, v6, v11
    v_perm_b32 v6, v16, v16, s55
    v_and_b32 v80, v6, v8
    v_and_b32 v81, v6, v9
    v_and_b32 v82, v6, v10
    v_and_b32 v83, v6, v11
    v_mfma_f32_16x16x32_bf16 v[12:15], v[76:79], v[28:31], 0
    v_perm_b32 v6, v17, v17, s54
    v_and_b32 v76, v6, v8
    v_and_b32 v77, v6, v9
    v_and_b32 v78, v6, v10
    v_and_b32 v79, v6, v11
    v_mfma_f32_16x16x32_bf16 v[12:15], v[80:83], v[32:35], v[12:15]
    v_perm_b32 v6, v17, v17, s55
    v_and_b32 v80, v6, v8
    v_and_b32 v81, v6, v9
    v_and_b32 v82, v6, v10
    v_and_b32 v83, v6, v11
    v_mfma_f32_16x16x32_bf16 v[12:15], v[76:79], v[36:39], v[12:15]
    v_perm_b32 v6, v18, v18, s54
    v_and_b32 v76, v6, v8
    v_and_b32 v77, v6, v9
    v_and_b32 v78, v6, v10
    v_and_b32 v79, v6, v11
    v_mfma_f32_16x16x32_bf16 v[12:15], v[80:83], v[40:43], v[12:15]
    v_perm_b32 v6, v18, v18, s55
    v_and_b32 v80, v6, v8
    v_and_b32 v81, v6, v9
    v_and_b32 v82, v6, v10
    v_and_b32 v83, v6, v11
    v_mfma_f32_16x16x32_bf16 v[12:15], v[76:79], v[44:47], v[12:15]
    v_perm_b32 v6, v19, v19, s54
    v_and_b32 v76, v6, v8
    v_and_b32 v77, v6, v9
    v_and_b32 v78, v6, v10
    v_and_b32 v79, v6, v11
    v_mfma_f32_16x16x32_bf16 v[12:15], v[80:83], v[48:51], v[12:15]
    v_perm_b32 v6, v19, v19, s55
    v_and_b32 v80, v6, v8
    v_and_b32 v81, v6, v9
    v_and_b32 v82, v6, v10
    v_and_b32 v83, v6, v11
    v_mfma_f32_16x16x32_bf16 v[12:15], v[76:79], v[52:55], v[12:15]
    v_perm_b32 v6, v20, v20, s54
    v_and_b32 v76, v6, v8
    v_and_b32 v77, v6, v9
    v_and_b32 v78, v6, v10
    v_and_b32 v79, v6, v11
    v_mfma_f32_16x16x32_bf16 v[12:15], v[80:83], v[56:59], v[12:15]
    s_cbranch_scc1 L_W8b
    v_perm_b32 v6, v20, v20, s55
    v_and_b32 v80, v6, v8
    v_and_b32 v81, v6, v9
    v_and_b32 v82, v6, v10
    v_and_b32 v83, v6, v11
    v_mfma_f32_16x16x32_bf16 v[12:15], v[76:79], v[60:63], v[12:15]
    s_nop 0
    v_mfma_f32_16x16x32_bf16 v[12:15], v[80:83], v[64:67], v[12:15]
L_W8b:
    s_nop 7
    v_permlane32_swap_b32 v12, v14
    v_permlane32_swap_b32 v13, v15
    s_nop 1
    v_add_f32_dpp v12, v14, v12 row_ror:8 row_mask:0xf bank_mask:0xf
    v_add_f32_dpp v13, v15, v13 row_ror:8 row_mask:0xf bank_mask:0xf
    s_mov_b32 exec_lo, 0x00ff00ff
    s_mov_b32 exec_hi, 0x00ff00ff
    global_store_dwordx2 v124, v[12:13], s[28:29] offset:-256
L_spin_1:
    ds_read_b32 v6, v5 offset:27408
    s_waitcnt lgkmcnt(0)
    v_readfirstlane_b32 s36, v6
    s_cmp_lg_u32 s36, 0
    s_cbranch_scc1 L_done_2
    s_sleep 4
    s_sub_u32 s35, s35, 1
    s_cbranch_scc0 L_spin_1
    s_branch L_end
L_done_2:
    s_cmp_eq_u32 s36, 1
    s_cbranch_scc1 L_Wdone
    s_waitcnt vmcnt(0)
    global_store_dwordx2 v124, v[12:13], s[28:29] offset:-256 sc1
L_Wdone:
    s_mov_b64 exec, -1
    s_branch L_A2
L_w0b:
    s_getreg_b32 s37, hwreg(HW_REG_XCC_ID, 0, 4)
    s_mul_i32 s38, s37, s37
    s_lshl_b32 s38, s38, 10
    s_add_u32 s37, s37, s38
    s_lshl_b32 s37, s37, 8
    s_add_u32 s37, s37, 1
    s_and_b32 s46, s2, 7
    s_lshl_b32 s46, s46, 5
    s_mov_b32 s38, s37
    s_waitcnt vmcnt(0)
    s_atomic_add s38, s[26:27], s46 glc
    s_barrier
    s_waitcnt lgkmcnt(0)
    s_add_u32 s38, s38, s37
    s_lshl_b32 s37, s37, 5
    s_cmp_lg_u32 s38, s37
    s_cbranch_scc1 L_notlast
    s_mov_b32 exec_hi, 0
    s_mul_i32 s36, s46, 1664
    v_mul_u32_u24 v6, 1664, v0
    v_add_u32 v6, s36, v6
    global_store_dword v6, v5, s[28:29] offset:1280
L_notlast:
    s_mov_b64 exec, 1
    s_mov_b32 s59, 1
    s_mov_b32 s38, 8
    v_mov_b32 v6, s46
L_allclr:
    global_load_dword v127, v124, s[28:29] offset:1280 sc1
    s_waitcnt vmcnt(0)
    v_cmp_eq_u32 vcc, 0, v127
    s_cbranch_vccnz L_local
    s_sub_u32 s38, s38, 1
    s_cbranch_scc0 L_allclr
L_allclr1:
    s_sub_u32 s35, s35, 16
    s_cbranch_scc1 L_end
    global_load_dword v127, v6, s[26:27] sc1
    s_waitcnt vmcnt(0)
    v_readfirstlane_b32 s36, v127
    s_and_b32 s38, s36, 0xe0
    s_cbranch_scc0 L_allclr1
    s_cmp_eq_u32 s36, s37
    s_cbranch_scc1 L_local
    s_mov_b32 s59, 2
    s_mov_b64 exec, -1
    global_store_dwordx4 v124, v[12:15], s[28:29] sc1
    global_store_dwordx4 v125, v[12:15], s[28:29] offset:1024 sc1
    global_store_dwordx4 v126, v[12:15], s[28:29] offset:1280 sc1
    s_mov_b64 exec, 1
    s_add_u32 s46, s46, 16
    s_mov_b32 s37, 1
    v_mov_b32 v126, s46
    s_waitcnt vmcnt(0)
    s_atomic_add s37, s[26:27], s46
L_allclr2:
    s_sub_u32 s35, s35, 16
    s_cbranch_scc1 L_end
    s_sleep 16
    global_load_dword v7, v126, s[26:27] sc1
    s_waitcnt vmcnt(0) lgkmcnt(0)
    v_readfirstlane_b32 s36, v7
    s_cmp_lt_u32 s36, 32
    s_cbranch_scc1 L_allclr2
L_local:
    v_mov_b32 v6, s59
    ds_write_b32 v5, v6 offset:27408
    s_mov_b32 exec_lo, -1
    s_mov_b32 exec_hi, 0xffff
    s_lshr_b32 s36, s39, 3
    s_mul_i32 s36, s36, 13312
    s_add_u32 s36, s36, 3328
    v_lshl_add_u32 v124, v0, 4, s36
    v_add_u32 v125, 6656, v124
L_qgather:
    s_sub_u32 s35, s35, 16
    s_cbranch_scc1 L_end
    global_load_dwordx4 v[76:79], v124, s[28:29] offset:-3328 sc1
    global_load_dwordx4 v[80:83], v124, s[28:29] offset:-1664 sc1
    global_load_dwordx4 v[84:87], v124, s[28:29] offset:0 sc1
    global_load_dwordx4 v[88:91], v124, s[28:29] offset:1664 sc1
    global_load_dwordx4 v[92:95], v125, s[28:29] offset:-3328 sc1
    global_load_dwordx4 v[96:99], v125, s[28:29] offset:-1664 sc1
    global_load_dwordx4 v[100:103], v125, s[28:29] offset:0 sc1
    global_load_dwordx4 v[104:107], v125, s[28:29] offset:1664 sc1
    s_waitcnt vmcnt(0)
    v_max3_u32 v6, v76, v77, v78
    v_max3_u32 v6, v6, v79, v80
    v_max3_u32 v6, v6, v81, v82
    v_max3_u32 v6, v6, v83, v84
    v_max3_u32 v6, v6, v85, v86
    v_max3_u32 v6, v6, v87, v88
    v_max3_u32 v6, v6, v89, v90
    v_max3_u32 v6, v6, v91, v92
    v_max3_u32 v6, v6, v93, v94
    v_max3_u32 v6, v6, v95, v96
    v_max3_u32 v6, v6, v97, v98
    v_max3_u32 v6, v6, v99, v100
    v_max3_u32 v6, v6, v101, v102
    v_max3_u32 v6, v6, v103, v104
    v_max3_u32 v6, v6, v105, v106
    v_max_u32 v6, v6, v107
    v_cmp_eq_u32 vcc, -1, v6
    s_cbranch_vccnz L_qgather
    v_pk_add_f32 v[76:77], v[76:77], v[80:81]
    v_pk_add_f32 v[78:79], v[78:79], v[82:83]
    v_pk_add_f32 v[76:77], v[76:77], v[84:85]
    v_pk_add_f32 v[78:79], v[78:79], v[86:87]
    v_pk_add_f32 v[76:77], v[76:77], v[88:89]
    v_pk_add_f32 v[78:79], v[78:79], v[90:91]
    v_pk_add_f32 v[76:77], v[76:77], v[92:93]
    v_pk_add_f32 v[78:79], v[78:79], v[94:95]
    v_pk_add_f32 v[76:77], v[76:77], v[96:97]
    v_pk_add_f32 v[78:79], v[78:79], v[98:99]
    v_pk_add_f32 v[76:77], v[76:77], v[100:101]
    v_pk_add_f32 v[78:79], v[78:79], v[102:103]
    v_pk_add_f32 v[76:77], v[76:77], v[104:105]
    v_pk_add_f32 v[78:79], v[78:79], v[106:107]
    v_cvt_pk_bf16_f32 v76, v76, v77
    v_cvt_pk_bf16_f32 v77, v78, v79
    v_lshlrev_b32 v124, 3, v0
    ds_write_b64 v124, v[76:77] offset:26624
    v_mov_b32 v6, s59
    ds_write_b32 v5, v6 offset:27412
    s_mov_b64 exec, -1
    s_branch L_A
L_pad0:
    s_branch L_padret0
L_w67:
    s_cmp_eq_u32 s3, 7
    s_cbranch_scc1 L_A7
    s_cmpk_ge_u32 s2, 240
    s_cbranch_scc1 L_w7
    v_mul_u32_u24 v124, 20, v0
    v_mov_b32 v12, 0
    s_waitcnt lgkmcnt(0)
    s_barrier
    global_load_dwordx4 v[16:19], v124, s[4:5]
    global_load_dword v20, v124, s[4:5] offset:16
    global_load_dwordx4 v[22:25], v124, s[22:23]
    global_load_dword v26, v124, s[22:23] offset:16
    s_waitcnt vmcnt(0)
    v_lshlrev_b32 v6, 16, v16
    v_lshlrev_b32 v7, 16, v22
    v_mul_f32 v6, v6, v7
    v_and_b32 v124, 0xffff0000, v16
    v_and_b32 v7, 0xffff0000, v22
    v_mul_f32 v7, v124, v7
    v_cvt_pk_bf16_f32 v6, v6, v7
    v_lshlrev_b32 v7, 16, v6
    v_and_b32 v6, 0xffff0000, v6
    v_add_f32 v12, v12, v7
    v_add_f32 v12, v12, v6
    v_lshlrev_b32 v6, 16, v17
    v_lshlrev_b32 v7, 16, v23
    v_mul_f32 v6, v6, v7
    v_and_b32 v124, 0xffff0000, v17
    v_and_b32 v7, 0xffff0000, v23
    v_mul_f32 v7, v124, v7
    v_cvt_pk_bf16_f32 v6, v6, v7
    v_lshlrev_b32 v7, 16, v6
    v_and_b32 v6, 0xffff0000, v6
    v_add_f32 v12, v12, v7
    v_add_f32 v12, v12, v6
    v_lshlrev_b32 v6, 16, v18
    v_lshlrev_b32 v7, 16, v24
    v_mul_f32 v6, v6, v7
    v_and_b32 v124, 0xffff0000, v18
    v_and_b32 v7, 0xffff0000, v24
    v_mul_f32 v7, v124, v7
    v_cvt_pk_bf16_f32 v6, v6, v7
    v_lshlrev_b32 v7, 16, v6
    v_and_b32 v6, 0xffff0000, v6
    v_add_f32 v12, v12, v7
    v_add_f32 v12, v12, v6
    v_lshlrev_b32 v6, 16, v19
    v_lshlrev_b32 v7, 16, v25
    v_mul_f32 v6, v6, v7
    v_and_b32 v124, 0xffff0000, v19
    v_and_b32 v7, 0xffff0000, v25
    v_mul_f32 v7, v124, v7
    v_cvt_pk_bf16_f32 v6, v6, v7
    v_lshlrev_b32 v7, 16, v6
    v_and_b32 v6, 0xffff0000, v6
    v_add_f32 v12, v12, v7
    v_add_f32 v12, v12, v6
    v_lshlrev_b32 v6, 16, v20
    v_lshlrev_b32 v7, 16, v26
    v_mul_f32 v6, v6, v7
    v_and_b32 v124, 0xffff0000, v20
    v_and_b32 v7, 0xffff0000, v26
    v_mul_f32 v7, v124, v7
    v_cvt_pk_bf16_f32 v6, v6, v7
    v_lshlrev_b32 v7, 16, v6
    v_and_b32 v6, 0xffff0000, v6
    v_add_f32 v12, v12, v7
    v_add_f32 v12, v12, v6
    s_nop 1
    v_add_f32_dpp v12, v12, v12 quad_perm:[1,0,3,2] row_mask:0xf bank_mask:0xf
    s_nop 1
    v_add_f32_dpp v12, v12, v12 quad_perm:[2,3,0,1] row_mask:0xf bank_mask:0xf
    s_nop 1
    v_add_f32_dpp v12, v12, v12 row_half_mirror row_mask:0xf bank_mask:0xf
    s_nop 1
    v_add_f32_dpp v12, v12, v12 row_mirror row_mask:0xf bank_mask:0xf
    s_nop 1
    v_add_f32_dpp v12, v12, v12 row_bcast:15 row_mask:0xa bank_mask:0xf
    s_nop 1
    v_add_f32_dpp v12, v12, v12 row_bcast:31 row_mask:0xc bank_mask:0xf
    v_cvt_pk_bf16_f32 v12, v12, v12
    v_lshlrev_b32 v12, 16, v12
    v_mul_f32 v12, 0xbfb8aa3b, v12
    v_exp_f32 v12, v12
    s_nop 0
    v_add_f32 v12, 1.0, v12
    v_rcp_f32 v12, v12
    s_nop 0
    v_cvt_pk_bf16_f32 v12, v12, v12
    v_lshlrev_b32 v12, 16, v12
    v_sub_f32 v13, 1.0, v12
    v_cvt_pk_bf16_f32 v13, v13, v13
    v_lshlrev_b32 v13, 16, v13
    s_nop 0
    v_readlane_b32 s60, v12, 63
    v_readlane_b32 s61, v13, 63
L_spin_3:
    ds_read_b32 v6, v5 offset:27412
    s_waitcnt lgkmcnt(0)
    v_readfirstlane_b32 s36, v6
    s_cmp_lg_u32 s36, 0
    s_cbranch_scc1 L_done_4
    s_sleep 4
    s_sub_u32 s35, s35, 1
    s_cbranch_scc0 L_spin_3
    s_branch L_end
L_pad1:
    s_branch L_padret1
L_done_4:
    s_mul_i32 s36, s34, 1664
    s_sub_u32 s36, s32, s36
    s_add_u32 s36, s36, 4096
    v_and_b32 v6, 31, v0
    v_lshl_add_u32 v124, v6, 4, s36
    v_lshrrev_b32 v6, 5, v0
    v_mul_u32_u24 v6, 8320, v6
    v_add_u32 v124, v124, v6
L_fgather:
    s_sub_u32 s35, s35, 16
    s_cbranch_scc1 L_end
    global_load_dwordx4 v[76:79], v124, s[28:29] offset:-3328 sc1
    global_load_dwordx4 v[80:83], v124, s[28:29] offset:-1664 sc1
    global_load_dwordx4 v[84:87], v124, s[28:29] offset:0 sc1
    global_load_dwordx4 v[88:91], v124, s[28:29] offset:1664 sc1
    global_load_dwordx4 v[92:95], v124, s[28:29] offset:3328 sc1
    s_waitcnt vmcnt(0)
    v_max3_u32 v6, v76, v77, v78
    v_max3_u32 v6, v6, v79, v80
    v_max3_u32 v6, v6, v81, v82
    v_max3_u32 v6, v6, v83, v84
    v_max3_u32 v6, v6, v85, v86
    v_max3_u32 v6, v6, v87, v88
    v_max3_u32 v6, v6, v89, v90
    v_max3_u32 v6, v6, v91, v92
    v_max3_u32 v6, v6, v93, v94
    v_max_u32 v6, v6, v95
    v_cmp_eq_u32 vcc, -1, v6
    s_cbranch_vccnz L_fgather
    v_pk_add_f32 v[76:77], v[76:77], v[80:81]
    v_pk_add_f32 v[78:79], v[78:79], v[82:83]
    v_pk_add_f32 v[76:77], v[76:77], v[84:85]
    v_pk_add_f32 v[78:79], v[78:79], v[86:87]
    v_pk_add_f32 v[76:77], v[76:77], v[88:89]
    v_pk_add_f32 v[78:79], v[78:79], v[90:91]
    v_pk_add_f32 v[76:77], v[76:77], v[92:93]
    v_pk_add_f32 v[78:79], v[78:79], v[94:95]
    s_nop 1
    v_permlane32_swap_b32 v76, v78
    v_permlane32_swap_b32 v77, v79
    v_pk_add_f32 v[76:77], v[76:77], v[78:79]
    s_nop 1
    v_permlane16_swap_b32 v76, v77
    v_cvt_pk_bf16_f32 v76, v76, v77
    v_and_b32 v77, 0xffff0000, v76
    v_lshlrev_b32 v76, 16, v76
    v_mul_f32 v6, 0xbfb8aa3b, v76
    v_exp_f32 v6, v6
    s_nop 0
    v_add_f32 v6, 1.0, v6
    v_rcp_f32 v6, v6
    s_nop 0
    v_mul_f32 v76, v76, v6
    v_cvt_pk_bf16_f32 v76, v76, v76
    v_lshlrev_b32 v76, 16, v76
    v_mul_f32 v76, v76, v77
    v_cvt_pk_bf16_f32 v76, v76, v76
    v_lshlrev_b32 v76, 16, v76
    v_mul_f32 v76, s61, v76
    v_cvt_pk_bf16_f32 v76, v76, v76
    v_and_b32 v6, 15, v0
    v_lshlrev_b32 v6, 4, v6
    v_lshrrev_b32 v7, 4, v0
    v_lshl_add_u32 v6, v7, 2, v6
    ds_write_b32 v6, v76 offset:27008
    v_mov_b32 v6, 1
    v_mov_b32 v7, s60
    ds_write_b64 v5, v[6:7] offset:27416
    s_branch L_A
L_A7:
    s_mov_b32 vcc_lo, 0
    s_mov_b32 vcc_hi, 2
    v_mov_b32 v7, 0xff800000
    v_lshlrev_b32 v6, 2, v0
    v_cndmask_b32 v7, 0, v7, vcc
    ds_write_b32 v6, v7 offset:27264
    v_mov_b32 v6, 25
    ds_write_b32 v5, v6 offset:27428
    s_waitcnt lgkmcnt(0)
    s_barrier
    s_branch L_pad0
L_padret0:
    s_branch L_pad1
L_padret1:
    s_branch L_pad2
L_padret2:
    s_branch L_pad3
L_padret3:
    s_branch L_pad4
L_padret4:
    s_branch L_pad5
L_padret5:
    s_branch L_pad6
L_padret6:
L_spin_5:
    ds_read_b32 v6, v5 offset:27408
    s_waitcnt lgkmcnt(0)
    v_readfirstlane_b32 s36, v6
    s_cmp_lg_u32 s36, 0
    s_cbranch_scc1 L_done_6
    s_sleep 8
    s_sub_u32 s35, s35, 1
    s_cbranch_scc0 L_spin_5
    s_branch L_end
L_done_6:
    v_lshlrev_b32 v124, 5, v2
L_allgrp:
    s_sub_u32 s35, s35, 16
    s_cbranch_scc1 L_end
    global_load_dword v12, v124, s[26:27] sc1
    s_waitcnt vmcnt(0)
    v_and_b32 v12, 0xe0, v12
    v_cmp_eq_u32 vcc, 0, v12
    s_cbranch_vccnz L_allgrp
    v_mov_b32 v6, 1
    ds_write_b32 v5, v6 offset:27436
    s_movk_i32 s45, 123
    s_mov_b32 s44, 692480
    s_mov_b32 s46, 0x19181715
    s_mov_b32 s47, 0x2a201c1a
    s_call_b64 s[76:77], L_cp
    s_branch L_A
L_w7:
    s_waitcnt lgkmcnt(0)
    s_barrier
L_A:
    v_and_b32 v6, 1, v0
    v_lshlrev_b32 v6, 4, v6
    v_mov_b32 v7, 0xffff
    v_lshlrev_b32 v6, v6, v7
    v_lshrrev_b32 v7, 1, v2
    v_cmp_eq_u32 s[40:41], 0, v7
    v_cmp_eq_u32 s[42:43], 1, v7
    v_cmp_eq_u32 s[44:45], 2, v7
    v_cmp_eq_u32 s[46:47], 3, v7
    v_cndmask_b32 v8, 0, v6, s[40:41]
    v_cndmask_b32 v9, 0, v6, s[42:43]
    v_cndmask_b32 v10, 0, v6, s[44:45]
    v_cndmask_b32 v11, 0, v6, s[46:47]
L_A2:
    v_add_u32 v3, 1536, v3
    v_bfe_u32 v124, v3, 0, 12
    v_or_b32 v124, s74, v124
    v_mul_u32_u24 v124, 384, v124
    v_lshl_add_u32 v124, v2, 4, v124
    v_add_u32 v3, 512, v3
    v_bfe_u32 v125, v3, 0, 12
    v_or_b32 v125, s74, v125
    v_mul_u32_u24 v125, 384, v125
    v_lshl_add_u32 v125, v2, 4, v125
    v_add_u32 v3, 512, v3
    v_bfe_u32 v126, v3, 0, 12
    v_or_b32 v126, s74, v126
    v_mul_u32_u24 v126, 384, v126
    v_lshl_add_u32 v126, v2, 4, v126
    v_add_u32 v3, 512, v3
    v_bfe_u32 v127, v3, 0, 12
    v_or_b32 v127, s74, v127
    v_mul_u32_u24 v127, 384, v127
    v_lshl_add_u32 v127, v2, 4, v127
    s_mov_b32 s57, 1
    s_mul_i32 s58, s3, 3
    s_addk_i32 s58, 195
    s_mov_b32 s75, 3
    s_waitcnt vmcnt(0)
    s_call_b64 s[76:77], L_gate
    global_load_dwordx4 v[28:31], v124, s[6:7] offset:0 nt
    global_load_dwordx4 v[32:35], v124, s[6:7] offset:128 nt
    global_load_dwordx4 v[36:39], v124, s[6:7] offset:256 nt
    s_branch L_S1
L_pad2:
    s_branch L_padret2
L_pace:
    s_mov_b64 exec, 1
    s_add_u32 s58, s58, 24
    s_waitcnt vmcnt(9)
L_pl:
    s_sub_u32 s35, s35, 1
    s_cbranch_scc1 L_end
    s_getreg_b32 s36, hwreg(HW_REG_IB_STS, 0, 4)
    s_sub_u32 s38, s75, s36
    v_mov_b32 v4, s38
    s_mov_b32 s75, s36
    ds_add_rtn_u64 v[6:7], v5, v[4:5] offset:27424
    s_sub_u32 s38, s58, s38
    s_waitcnt lgkmcnt(0)
    v_add_u32 v6, v6, v7
    v_cmp_gt_i32 vcc, s38, v6
    s_cbranch_vccnz L_pl
    s_add_u32 s75, s75, 3
L_pret:
    s_mov_b64 exec, -1
    s_setpc_b64 s[76:77]
L_gate:
    ds_read_b64 v[6:7], v5 offset:27424
    s_waitcnt lgkmcnt(0)
    v_readfirstlane_b32 s36, v6
    v_readfirstlane_b32 s37, v7
    s_add_u32 s36, s36, s37
    s_cmp_ge_u32 s36, s58
    s_cbranch_scc1 L_pret
    s_sleep 1
    s_sub_u32 s35, s35, 1
    s_cbranch_scc0 L_gate
    s_branch L_end
L_cp:
    s_lshr_b32 s37, s2, 5
    s_mul_i32 s37, s37, 2944
    s_add_u32 s44, s44, s37
L_spin_7:
    ds_read_b32 v6, v5 offset:27424
    s_waitcnt lgkmcnt(0)
    v_readfirstlane_b32 s36, v6
    s_cmp_ge_u32 s36, s45
    s_cbranch_scc1 L_done_8
    s_sleep 1
    s_sub_u32 s35, s35, 1
    s_cbranch_scc0 L_spin_7
    s_branch L_end
L_done_8:
    s_mov_b32 s36, 1
    s_atomic_add s36, s[28:29], s44 glc
    s_waitcnt lgkmcnt(0)
    s_add_u32 s36, s36, 1
    s_lshr_b32 s36, s36, 2
    s_and_b32 s36, s36, 7
    s_lshl_b32 s36, s36, 3
    s_lshr_b64 s[46:47], s[46:47], s36
    s_and_b32 s36, s46, 0xff
    v_mov_b32 v6, s36
    ds_write_b32 v5, v6 offset:27428
    s_setpc_b64 s[76:77]
L_Bgo:
    s_load_dwordx16 s[4:19], s[0:1], 0
    s_load_dwordx8 s[20:27], s[0:1], 64
    s_load_dwordx2 s[28:29], s[0:1], 96
    v_bfe_u32 v1, v0, 6, 3
    v_and_b32 v0, 63, v0
    v_readfirstlane_b32 s3, v1
    v_lshrrev_b32 v1, 3, v0
    s_bfe_u32 s39, s39, 0x80003
    s_and_b32 s31, s39, 7
    v_add_u32 v3, 512, v3
    v_bfe_u32 v125, v3, 0, 12
    v_or_b32 v125, s74, v125
    v_mul_u32_u24 v125, 384, v125
    v_lshl_add_u32 v125, v2, 4, v125
    v_add_u32 v3, 512, v3
    v_bfe_u32 v126, v3, 0, 12
    v_or_b32 v126, s74, v126
    v_mul_u32_u24 v126, 384, v126
    v_lshl_add_u32 v126, v2, 4, v126
    v_add_u32 v3, 512, v3
    v_bfe_u32 v127, v3, 0, 12
    v_or_b32 v127, s74, v127
    v_mul_u32_u24 v127, 384, v127
    v_lshl_add_u32 v127, v2, 4, v127
    s_lshr_b32 s38, s2, 3
    s_mul_i32 s37, s38, 26
    s_lshr_b32 s37, s37, 8
    s_and_b32 s33, s2, 7
    s_mul_i32 s33, s33, 3
    s_add_u32 s33, s33, s37
    s_mul_i32 s37, s37, 10
    s_sub_u32 s34, s38, s37
    s_mul_i32 s32, s39, 1664
    s_mov_b32 s35, 0x200000
    v_mov_b32 v5, 0
    v_and_b32 v6, 1, v0
    v_lshlrev_b32 v6, 4, v6
    v_mov_b32 v7, 0xffff
    v_lshlrev_b32 v6, v6, v7
    v_lshrrev_b32 v7, 1, v2
    v_cmp_eq_u32 s[40:41], 0, v7
    v_cmp_eq_u32 s[42:43], 1, v7
    v_cmp_eq_u32 s[44:45], 2, v7
    v_cmp_eq_u32 s[46:47], 3, v7
    v_cndmask_b32 v8, 0, v6, s[40:41]
    v_cndmask_b32 v9, 0, v6, s[42:43]
    v_cndmask_b32 v10, 0, v6, s[44:45]
    v_cndmask_b32 v11, 0, v6, s[46:47]
    s_mov_b32 s57, 0
    s_mul_i32 s58, s3, 3
    s_addk_i32 s58, 3
    s_mov_b32 s75, 3
    s_waitcnt lgkmcnt(0)
    s_barrier
L_S1:
    s_call_b64 s[76:77], L_pace
    global_load_dwordx4 v[40:43], v125, s[6:7] offset:0 nt
    global_load_dwordx4 v[44:47], v125, s[6:7] offset:128 nt
    global_load_dwordx4 v[48:51], v125, s[6:7] offset:256 nt
    s_call_b64 s[76:77], L_pace
    global_load_dwordx4 v[52:55], v126, s[6:7] offset:0 nt
    global_load_dwordx4 v[56:59], v126, s[6:7] offset:128 nt
    global_load_dwordx4 v[60:63], v126, s[6:7] offset:256 nt
    s_call_b64 s[76:77], L_pace
    global_load_dwordx4 v[64:67], v127, s[6:7] offset:0 nt
    global_load_dwordx4 v[68:71], v127, s[6:7] offset:128 nt
    global_load_dwordx4 v[72:75], v127, s[6:7] offset:256 nt
    s_call_b64 s[76:77], L_pace
    global_load_dwordx4 v[76:79], v124, s[8:9] offset:0 nt
    global_load_dwordx4 v[80:83], v124, s[8:9] offset:128 nt
    global_load_dwordx4 v[84:87], v124, s[8:9] offset:256 nt
    s_cmp_eq_u32 s57, 1
    s_cbranch_scc1 L_qkA
L_V1:
    s_call_b64 s[76:77], L_pace
    global_load_dwordx4 v[88:91], v125, s[8:9] offset:0 nt
    global_load_dwordx4 v[92:95], v125, s[8:9] offset:128 nt
    global_load_dwordx4 v[96:99], v125, s[8:9] offset:256 nt
    s_call_b64 s[76:77], L_pace
    global_load_dwordx4 v[100:103], v126, s[8:9] offset:0 nt
    global_load_dwordx4 v[104:107], v126, s[8:9] offset:128 nt
    global_load_dwordx4 v[108:111], v126, s[8:9] offset:256 nt
    s_call_b64 s[76:77], L_pace
    global_load_dwordx4 v[112:115], v127, s[8:9] offset:0 nt
    global_load_dwordx4 v[116:119], v127, s[8:9] offset:128 nt
    global_load_dwordx4 v[120:123], v127, s[8:9] offset:256 nt
    s_sub_u32 s36, s75, 3
    s_waitcnt vmcnt(3)
    v_mov_b32 v4, s36
    s_mov_b64 exec, 1
    ds_add_u32 v5, v4 offset:27424
    s_mov_b64 exec, -1
    s_cmp_eq_u32 s57, 1
    s_cbranch_scc1 L_pv
    s_waitcnt vmcnt(0)
    s_mov_b32 s75, 6
L_qkA:
    s_sub_u32 s36, s75, 3
    s_mov_b32 s75, 3
    s_waitcnt vmcnt(3)
    v_mov_b32 v4, s36
    s_mov_b64 exec, 1
    ds_add_u32 v5, v4 offset:27424
    s_mov_b64 exec, -1
L_qk:
L_spin_9:
    ds_read_b32 v6, v5 offset:27412
    s_waitcnt lgkmcnt(0)
    v_readfirstlane_b32 s36, v6
    s_cmp_lg_u32 s36, 0
    s_cbranch_scc1 L_done_10
    s_sleep 2
    s_sub_u32 s35, s35, 1
    s_cbranch_scc0 L_spin_9
    s_branch L_end
L_pad3:
    s_branch L_padret3
L_done_10:
    s_mov_b32 s59, s36
    v_lshlrev_b32 v6, 4, v2
    ds_read_b128 v[16:19], v6 offset:26624
    ds_read_b128 v[20:23], v6 offset:26752
    ds_read_b128 v[24:27], v6 offset:26880
    s_mov_b32 s63, 0x3d93cd3a
    v_mov_b32 v12, 0
    v_mov_b32 v13, 0
    v_mov_b32 v14, 0
    v_mov_b32 v15, 0
    s_waitcnt vmcnt(3) lgkmcnt(0)
    v_dot2c_f32_bf16 v12, v28, v16
    v_dot2c_f32_bf16 v13, v40, v16
    v_dot2c_f32_bf16 v14, v52, v16
    v_dot2c_f32_bf16 v15, v64, v16
    v_dot2c_f32_bf16 v12, v29, v17
    v_dot2c_f32_bf16 v13, v41, v17
    v_dot2c_f32_bf16 v14, v53, v17
    v_dot2c_f32_bf16 v15, v65, v17
    v_dot2c_f32_bf16 v12, v30, v18
    v_dot2c_f32_bf16 v13, v42, v18
    v_dot2c_f32_bf16 v14, v54, v18
    v_dot2c_f32_bf16 v15, v66, v18
    v_dot2c_f32_bf16 v12, v31, v19
    v_dot2c_f32_bf16 v13, v43, v19
    v_dot2c_f32_bf16 v14, v55, v19
    v_dot2c_f32_bf16 v15, v67, v19
    v_dot2c_f32_bf16 v12, v32, v20
    v_dot2c_f32_bf16 v13, v44, v20
    v_dot2c_f32_bf16 v14, v56, v20
    v_dot2c_f32_bf16 v15, v68, v20
    v_dot2c_f32_bf16 v12, v33, v21
    v_dot2c_f32_bf16 v13, v45, v21
    v_dot2c_f32_bf16 v14, v57, v21
    v_dot2c_f32_bf16 v15, v69, v21
    v_dot2c_f32_bf16 v12, v34, v22
    v_dot2c_f32_bf16 v13, v46, v22
    v_dot2c_f32_bf16 v14, v58, v22
    v_dot2c_f32_bf16 v15, v70, v22
    v_dot2c_f32_bf16 v12, v35, v23
    v_dot2c_f32_bf16 v13, v47, v23
    v_dot2c_f32_bf16 v14, v59, v23
    v_dot2c_f32_bf16 v15, v71, v23
    v_dot2c_f32_bf16 v12, v36, v24
    v_dot2c_f32_bf16 v13, v48, v24
    v_dot2c_f32_bf16 v14, v60, v24
    v_dot2c_f32_bf16 v15, v72, v24
    v_dot2c_f32_bf16 v12, v37, v25
    v_dot2c_f32_bf16 v13, v49, v25
    v_dot2c_f32_bf16 v14, v61, v25
    v_dot2c_f32_bf16 v15, v73, v25
    v_dot2c_f32_bf16 v12, v38, v26
    v_dot2c_f32_bf16 v13, v50, v26
    v_dot2c_f32_bf16 v14, v62, v26
    v_dot2c_f32_bf16 v15, v74, v26
    v_dot2c_f32_bf16 v12, v39, v27
    v_dot2c_f32_bf16 v13, v51, v27
    v_dot2c_f32_bf16 v14, v63, v27
    v_dot2c_f32_bf16 v15, v75, v27
    v_add_f32_dpp v12, v12, v12 quad_perm:[1,0,3,2] row_mask:0xf bank_mask:0xf
    v_add_f32_dpp v13, v13, v13 quad_perm:[1,0,3,2] row_mask:0xf bank_mask:0xf
    v_add_f32_dpp v14, v14, v14 quad_perm:[1,0,3,2] row_mask:0xf bank_mask:0xf
    v_add_f32_dpp v15, v15, v15 quad_perm:[1,0,3,2] row_mask:0xf bank_mask:0xf
    v_add_f32_dpp v12, v12, v12 quad_perm:[2,3,0,1] row_mask:0xf bank_mask:0xf
    v_add_f32_dpp v13, v13, v13 quad_perm:[2,3,0,1] row_mask:0xf bank_mask:0xf
    v_add_f32_dpp v14, v14, v14 quad_perm:[2,3,0,1] row_mask:0xf bank_mask:0xf
    v_add_f32_dpp v15, v15, v15 quad_perm:[2,3,0,1] row_mask:0xf bank_mask:0xf
    v_add_f32_dpp v12, v12, v12 row_half_mirror row_mask:0xf bank_mask:0xf
    v_add_f32_dpp v13, v13, v13 row_half_mirror row_mask:0xf bank_mask:0xf
    v_add_f32_dpp v14, v14, v14 row_half_mirror row_mask:0xf bank_mask:0xf
    v_add_f32_dpp v15, v15, v15 row_half_mirror row_mask:0xf bank_mask:0xf
    v_cvt_pk_bf16_f32 v12, v12, v13
    v_cvt_pk_bf16_f32 v14, v14, v15
    v_and_b32 v13, 0xffff0000, v12
    v_lshlrev_b32 v12, 16, v12
    v_and_b32 v15, 0xffff0000, v14
    v_lshlrev_b32 v14, 16, v14
    v_mul_f32 v12, s63, v12
    v_mul_f32 v13, s63, v13
    v_mul_f32 v14, s63, v14
    v_mul_f32 v15, s63, v15
    v_cvt_pk_bf16_f32 v12, v12, v13
    v_cvt_pk_bf16_f32 v14, v14, v15
    v_and_b32 v13, 0xffff0000, v12
    v_lshlrev_b32 v12, 16, v12
    v_and_b32 v15, 0xffff0000, v14
    v_lshlrev_b32 v14, 16, v14
    s_mov_b32 s63, 0x3fb8aa3b
    v_mul_f32 v12, s63, v12
    v_mul_f32 v13, s63, v13
    v_mul_f32 v14, s63, v14
    v_mul_f32 v15, s63, v15
    v_max_f32 v6, v12, v13
    v_max3_f32 v6, v6, v14, v15
    s_nop 1
    v_max_f32_dpp v6, v6, v6 row_ror:8 row_mask:0xf bank_mask:0xf
    s_nop 1
    v_max_f32_dpp v6, v6, v6 row_bcast:15 row_mask:0xa bank_mask:0xf
    s_nop 1
    v_max_f32_dpp v6, v6, v6 row_bcast:31 row_mask:0xc bank_mask:0xf
    s_lshl_b32 s36, s57, 3
    v_readlane_b32 s56, v6, 63
    s_add_u32 s36, s36, s3
    s_lshl_b32 s36, s36, 3
    v_subrev_f32 v12, s56, v12
    v_subrev_f32 v13, s56, v13
    v_subrev_f32 v14, s56, v14
    v_subrev_f32 v15, s56, v15
    v_exp_f32 v12, v12
    v_exp_f32 v13, v13
    v_exp_f32 v14, v14
    v_exp_f32 v15, v15
    v_add_f32 v7, v12, v13
    v_add_f32 v7, v7, v14
    v_add_f32 v7, v7, v15
    v_mov_b32 v16, s36
    v_mov_b32 v4, 1
    v_add_f32_dpp v7, v7, v7 row_ror:8 row_mask:0xf bank_mask:0xf
    s_nop 1
    v_add_f32_dpp v7, v7, v7 row_bcast:15 row_mask:0xa bank_mask:0xf
    s_nop 1
    v_add_f32_dpp v7, v7, v7 row_bcast:31 row_mask:0xc bank_mask:0xf
    s_mov_b32 exec_lo, 0
    s_mov_b32 exec_hi, 0x80000000
    ds_write_b64 v16, v[6:7] offset:27264
    ds_max_f32 v5, v6 offset:27396
    ds_add_u32 v5, v4 offset:27392
    s_mov_b64 exec, -1
    s_cmp_eq_u32 s57, 1
    s_cbranch_scc1 L_V1
    s_cmp_lg_u32 s3, 0
    s_cbranch_scc1 L_pv
L_spin_11:
    ds_read_b32 v6, v5 offset:27436
    s_waitcnt lgkmcnt(0)
    v_readfirstlane_b32 s36, v6
    s_cmp_eq_u32 s36, 1
    s_cbranch_scc1 L_done_12
    s_sleep 2
    s_sub_u32 s35, s35, 1
    s_cbranch_scc0 L_spin_11
    s_branch L_end
L_done_12:
    s_movk_i32 s45, 195
    s_mov_b32 s44, 716032
    s_mov_b32 s46, 0x19181716
    s_mov_b32 s47, 0x241d1b1a
    s_call_b64 s[76:77], L_cp
    s_movk_i32 s45, 260
    s_mov_b32 s44, 692608
    s_mov_b32 s46, 0x19181716
    s_mov_b32 s47, 0x241d1b1a
    s_call_b64 s[76:77], L_cp
L_pv:
L_spin_13:
    ds_read_b64 v[6:7], v5 offset:27392
    s_waitcnt lgkmcnt(0)
    v_readfirstlane_b32 s36, v6
    s_cmp_eq_u32 s36, 16
    s_cbranch_scc1 L_done_14
    s_sleep 2
    s_sub_u32 s35, s35, 1
    s_cbranch_scc0 L_spin_13
    s_branch L_end
L_done_14:
    v_sub_f32 v6, s56, v7
    v_exp_f32 v6, v6
    s_mul_i32 s36, s3, 3072
    v_mul_f32 v12, v12, v6
    v_mul_f32 v13, v13, v6
    v_mul_f32 v14, v14, v6
    v_mul_f32 v15, v15, v6
    v_cvt_pk_bf16_f32 v12, v12, v12
    v_cvt_pk_bf16_f32 v13, v13, v13
    v_cvt_pk_bf16_f32 v14, v14, v14
    v_cvt_pk_bf16_f32 v15, v15, v15
    v_and_b32 v28, v12, v8
    v_and_b32 v29, v12, v9
    v_and_b32 v30, v12, v10
    v_and_b32 v31, v12, v11
    v_and_b32 v32, v13, v8
    v_and_b32 v33, v13, v9
    v_and_b32 v34, v13, v10
    v_and_b32 v35, v13, v11
    v_and_b32 v36, v14, v8
    v_and_b32 v37, v14, v9
    v_and_b32 v38, v14, v10
    v_and_b32 v39, v14, v11
    v_and_b32 v40, v15, v8
    v_and_b32 v41, v15, v9
    v_and_b32 v42, v15, v10
    v_and_b32 v43, v15, v11
    v_lshl_add_u32 v124, v0, 4, s36
    s_cmp_eq_u32 s57, 1
    s_cbranch_scc1 L_pvA
    v_mfma_f32_16x16x32_bf16 v[44:47], v[28:31], v[76:79], 0
    v_mfma_f32_16x16x32_bf16 v[48:51], v[28:31], v[80:83], 0
    v_mfma_f32_16x16x32_bf16 v[52:55], v[28:31], v[84:87], 0
    v_mfma_f32_16x16x32_bf16 v[44:47], v[32:35], v[88:91], v[44:47]
    v_mfma_f32_16x16x32_bf16 v[48:51], v[32:35], v[92:95], v[48:51]
    v_mfma_f32_16x16x32_bf16 v[52:55], v[32:35], v[96:99], v[52:55]
    v_mfma_f32_16x16x32_bf16 v[44:47], v[36:39], v[100:103], v[44:47]
    v_mfma_f32_16x16x32_bf16 v[48:51], v[36:39], v[104:107], v[48:51]
    v_mfma_f32_16x16x32_bf16 v[52:55], v[36:39], v[108:111], v[52:55]
    v_mfma_f32_16x16x32_bf16 v[44:47], v[40:43], v[112:115], v[44:47]
    v_mfma_f32_16x16x32_bf16 v[48:51], v[40:43], v[116:119], v[48:51]
    v_mfma_f32_16x16x32_bf16 v[52:55], v[40:43], v[120:123], v[52:55]
    s_nop 5
    ds_write_b128 v124, v[44:47] offset:0
    ds_write_b128 v124, v[48:51] offset:1024
    ds_write_b128 v124, v[52:55] offset:2048
    v_mov_b32 v4, 1
    s_mov_b64 exec, 1
    ds_add_u32 v5, v4 offset:27400
    s_mov_b64 exec, -1
    s_cmp_lg_u32 s3, 6
    s_cbranch_scc1 L_tail
    v_and_b32 v6, 15, v0
    v_lshlrev_b32 v6, 3, v6
    ds_read_b64 v[12:13], v6 offset:27264
    s_mul_i32 s36, s31, 1656
    s_sub_u32 s36, s32, s36
    v_mov_b32 v14, v7
    v_mov_b32 v6, s36
    s_waitcnt lgkmcnt(0)
    v_sub_f32 v12, v12, v7
    v_exp_f32 v12, v12
    s_nop 0
    v_mul_f32 v15, v12, v13
    s_nop 1
    v_add_f32_dpp v15, v15, v15 quad_perm:[1,0,3,2] row_mask:0xf bank_mask:0xf
    s_nop 1
    v_add_f32_dpp v15, v15, v15 quad_perm:[2,3,0,1] row_mask:0xf bank_mask:0xf
    s_nop 1
    v_add_f32_dpp v15, v15, v15 row_half_mirror row_mask:0xf bank_mask:0xf
    s_nop 1
    v_add_f32_dpp v15, v15, v15 row_mirror row_mask:0xf bank_mask:0xf
    s_mov_b64 exec, 1
    s_cmp_eq_u32 s59, 1
    s_cbranch_scc1 L_mll
    global_store_dwordx2 v6, v[14:15], s[28:29] offset:1344 sc1
    s_branch L_mld
L_mll:
    global_store_dwordx2 v6, v[14:15], s[28:29] offset:1344
L_mld:
    s_mov_b64 exec, -1
    s_branch L_tail
L_pad4:
    s_branch L_padret4
L_pvA:
    s_setprio 3
L_spin_15:
    ds_read_b32 v6, v5 offset:27400
    s_waitcnt lgkmcnt(0)
    v_readfirstlane_b32 s36, v6
    s_cmp_eq_u32 s36, 8
    s_cbranch_scc1 L_done_16
    s_sleep 1
    s_sub_u32 s35, s35, 1
    s_cbranch_scc0 L_spin_15
    s_branch L_end
L_done_16:
    ds_read_b128 v[44:47], v124 offset:0
    ds_read_b128 v[48:51], v124 offset:1024
    ds_read_b128 v[52:55], v124 offset:2048
    s_waitcnt lgkmcnt(0)
    v_mfma_f32_16x16x32_bf16 v[44:47], v[28:31], v[76:79], v[44:47]
    v_mfma_f32_16x16x32_bf16 v[48:51], v[28:31], v[80:83], v[48:51]
    v_mfma_f32_16x16x32_bf16 v[52:55], v[28:31], v[84:87], v[52:55]
    v_mfma_f32_16x16x32_bf16 v[44:47], v[32:35], v[88:91], v[44:47]
    v_mfma_f32_16x16x32_bf16 v[48:51], v[32:35], v[92:95], v[48:51]
    v_mfma_f32_16x16x32_bf16 v[52:55], v[32:35], v[96:99], v[52:55]
    v_mfma_f32_16x16x32_bf16 v[44:47], v[36:39], v[100:103], v[44:47]
    v_mfma_f32_16x16x32_bf16 v[48:51], v[36:39], v[104:107], v[48:51]
    v_mfma_f32_16x16x32_bf16 v[52:55], v[36:39], v[108:111], v[52:55]
    v_lshlrev_b32 v125, 4, v0
    s_xor_b32 s36, s39, 16
    s_mul_i32 s36, s36, 768
    s_add_u32 s36, s36, 425984
    v_lshl_add_u32 v127, v2, 4, s36
    v_and_b32 v7, 48, v0
    v_lshl_add_u32 v127, v7, 3, v127
    v_and_b32 v7, 8, v0
    v_lshl_add_u32 v127, v7, 6, v127
    s_cmp_eq_u32 s3, 7
    s_waitcnt vmcnt(2)
    v_mfma_f32_16x16x32_bf16 v[44:47], v[40:43], v[112:115], v[44:47]
    s_waitcnt vmcnt(1)
    v_mfma_f32_16x16x32_bf16 v[48:51], v[40:43], v[116:119], v[48:51]
    s_waitcnt vmcnt(0)
    v_mfma_f32_16x16x32_bf16 v[52:55], v[40:43], v[120:123], v[52:55]
    s_cbranch_scc0 L_oslot
    ds_read_b32 v6, v5 offset:27432
    ds_read_b128 v[76:79], v125 offset:0
    ds_read_b128 v[80:83], v125 offset:3072
    ds_read_b128 v[84:87], v125 offset:6144
    ds_read_b128 v[88:91], v125 offset:9216
    ds_read_b128 v[92:95], v125 offset:12288
    ds_read_b128 v[96:99], v125 offset:15360
    ds_read_b128 v[100:103], v125 offset:18432
    v_permlane32_swap_b32 v44, v48
    v_permlane32_swap_b32 v45, v49
    v_permlane32_swap_b32 v46, v50
    v_permlane32_swap_b32 v47, v51
    v_add_f32_dpp v44, v48, v44 row_ror:8 row_mask:0xf bank_mask:0xf
    v_add_f32_dpp v45, v49, v45 row_ror:8 row_mask:0xf bank_mask:0xf
    v_add_f32_dpp v46, v50, v46 row_ror:8 row_mask:0xf bank_mask:0xf
    v_add_f32_dpp v47, v51, v47 row_ror:8 row_mask:0xf bank_mask:0xf
    v_permlane32_swap_b32 v52, v48
    v_permlane32_swap_b32 v53, v49
    v_permlane32_swap_b32 v54, v50
    v_permlane32_swap_b32 v55, v51
    v_add_f32_dpp v44, v52, v48 row_ror:8 row_mask:0x3 bank_mask:0xc
    v_add_f32_dpp v45, v53, v49 row_ror:8 row_mask:0x3 bank_mask:0xc
    v_add_f32_dpp v46, v54, v50 row_ror:8 row_mask:0x3 bank_mask:0xc
    v_add_f32_dpp v47, v55, v51 row_ror:8 row_mask:0x3 bank_mask:0xc
L_ocnt:
    s_waitcnt lgkmcnt(7)
    v_cmp_ne_u32 vcc, 7, v6
    s_cbranch_vccnz L_oretry
    s_cmp_eq_u32 s59, 1
    s_waitcnt lgkmcnt(6)
    v_pk_add_f32 v[44:45], v[44:45], v[76:77]
    v_pk_add_f32 v[46:47], v[46:47], v[78:79]
    s_waitcnt lgkmcnt(5)
    v_pk_add_f32 v[44:45], v[44:45], v[80:81]
    v_pk_add_f32 v[46:47], v[46:47], v[82:83]
    s_waitcnt lgkmcnt(4)
    v_pk_add_f32 v[44:45], v[44:45], v[84:85]
    v_pk_add_f32 v[46:47], v[46:47], v[86:87]
    s_waitcnt lgkmcnt(3)
    v_pk_add_f32 v[44:45], v[44:45], v[88:89]
    v_pk_add_f32 v[46:47], v[46:47], v[90:91]
    s_waitcnt lgkmcnt(2)
    v_pk_add_f32 v[44:45], v[44:45], v[92:93]
    v_pk_add_f32 v[46:47], v[46:47], v[94:95]
    s_waitcnt lgkmcnt(1)
    v_pk_add_f32 v[44:45], v[44:45], v[96:97]
    v_pk_add_f32 v[46:47], v[46:47], v[98:99]
    s_waitcnt lgkmcnt(0)
    v_pk_add_f32 v[44:45], v[44:45], v[100:101]
    v_pk_add_f32 v[46:47], v[46:47], v[102:103]
    s_mov_b32 exec_hi, 0x00ff00ff
    s_cbranch_scc0 L_opubr
    global_store_dwordx4 v127, v[44:47], s[28:29]
L_opubd:
    v_mov_b32 v4, 259
    s_mov_b64 exec, 1
    ds_add_u32 v5, v4 offset:27424
    s_mov_b64 exec, -1
    s_branch L_end
L_pad5:
    s_branch L_padret5
L_opubr:
    global_store_dwordx4 v127, v[44:47], s[28:29] sc1
    s_branch L_opubd
L_oretry:
    s_sub_u32 s35, s35, 1
    s_cbranch_scc1 L_end
    ds_read_b32 v6, v5 offset:27432
    ds_read_b128 v[76:79], v125 offset:0
    ds_read_b128 v[80:83], v125 offset:3072
    ds_read_b128 v[84:87], v125 offset:6144
    ds_read_b128 v[88:91], v125 offset:9216
    ds_read_b128 v[92:95], v125 offset:12288
    ds_read_b128 v[96:99], v125 offset:15360
    ds_read_b128 v[100:103], v125 offset:18432
    s_branch L_ocnt
L_oslot:
    v_mov_b32 v4, 3
    s_mov_b64 exec, 1
    ds_add_u32 v5, v4 offset:27424
    s_mov_b64 exec, -1
    s_nop 0
    v_permlane32_swap_b32 v44, v48
    v_permlane32_swap_b32 v45, v49
    v_permlane32_swap_b32 v46, v50
    v_permlane32_swap_b32 v47, v51
    v_add_f32_dpp v44, v48, v44 row_ror:8 row_mask:0xf bank_mask:0xf
    v_add_f32_dpp v45, v49, v45 row_ror:8 row_mask:0xf bank_mask:0xf
    v_add_f32_dpp v46, v50, v46 row_ror:8 row_mask:0xf bank_mask:0xf
    v_add_f32_dpp v47, v51, v47 row_ror:8 row_mask:0xf bank_mask:0xf
    v_permlane32_swap_b32 v52, v48
    v_permlane32_swap_b32 v53, v49
    v_permlane32_swap_b32 v54, v50
    v_permlane32_swap_b32 v55, v51
    v_add_f32_dpp v44, v52, v48 row_ror:8 row_mask:0x3 bank_mask:0xc
    v_add_f32_dpp v45, v53, v49 row_ror:8 row_mask:0x3 bank_mask:0xc
    v_add_f32_dpp v46, v54, v50 row_ror:8 row_mask:0x3 bank_mask:0xc
    v_add_f32_dpp v47, v55, v51 row_ror:8 row_mask:0x3 bank_mask:0xc
    ds_write_b128 v124, v[44:47] offset:0
    v_mov_b32 v4, 1
    s_mov_b64 exec, 1
    ds_add_u32 v5, v4 offset:27432
    s_mov_b64 exec, -1
    s_branch L_end
L_mlpoll:
    s_sub_u32 s35, s35, 16
    s_cbranch_scc1 L_end
    global_load_dwordx2 v[32:33], v17, s[28:29] offset:1344 sc1
    s_waitcnt vmcnt(0)
L_scale:
    v_max_f32_dpp v36, v32, v32 quad_perm:[1,0,3,2] row_mask:0xf bank_mask:0xf
    v_max_u32 v6, v32, v33
    v_cmp_eq_u32 vcc, -1, v6
    s_cbranch_vccnz L_mlpoll
    v_max_f32_dpp v36, v36, v36 quad_perm:[2,3,0,1] row_mask:0xf bank_mask:0xf
    s_nop 1
    v_max_f32_dpp v36, v36, v36 row_half_mirror row_mask:0xf bank_mask:0xf
    v_sub_f32 v32, v32, v36
    v_exp_f32 v32, v32
    s_nop 0
    v_mul_f32 v33, v33, v32
    s_nop 1
    v_add_f32_dpp v33, v33, v33 quad_perm:[1,0,3,2] row_mask:0xf bank_mask:0xf
    s_nop 1
    v_add_f32_dpp v33, v33, v33 quad_perm:[2,3,0,1] row_mask:0xf bank_mask:0xf
    s_nop 1
    v_add_f32_dpp v33, v33, v33 row_half_mirror row_mask:0xf bank_mask:0xf
    v_rcp_f32 v33, v33
    s_nop 0
    v_mul_f32 v33, v33, v24
    v_mul_f32 v36, v32, v33
    v_lshlrev_b32 v6, 2, v1
    ds_bpermute_b32 v36, v6, v36
    s_waitcnt lgkmcnt(0)
    s_setpc_b64 s[76:77]
L_tail:
    s_cmp_lg_u32 s3, 7
    s_cbranch_scc1 L_tail2
    s_movk_i32 s45, 322
    s_mov_b32 s44, 716160
    s_mov_b32 s46, 0x19181716
    s_mov_b32 s47, 0x241d1b1a
    s_call_b64 s[76:77], L_cp
L_tail2:
    s_cmpk_ge_u32 s2, 240
    s_cbranch_scc1 L_end
    s_lshl_b32 s36, s33, 3
    s_add_u32 s36, s36, s3
    s_mul_i32 s37, s36, 43691
    s_lshr_b32 s37, s37, 18
    s_mul_i32 s38, s37, 5376
    s_lshl_b32 s44, s36, 7
    s_add_u32 s38, s38, s44
    s_add_u32 s38, s38, 425984
    v_mul_u32_u24 v16, 768, v1
    v_lshl_add_u32 v16, v2, 4, v16
    v_add_u32 v16, s38, v16
    s_xor_b32 s37, s37, 2
    s_mul_i32 s37, s37, 13312
    v_lshl_add_u32 v17, v2, 3, s37
    s_lshl_b32 s38, s34, 7
    s_mul_i32 s37, s36, 40960
    s_and_b32 s44, s36, 1
    s_mul_i32 s44, s44, 35840
    s_sub_u32 s37, s37, s44
    s_add_u32 s37, s37, s38
    s_add_u32 s12, s12, s37
    s_addc_u32 s13, s13, 0
    s_mul_i32 s37, s36, 10240
    s_add_u32 s37, s37, s38
    s_add_u32 s20, s20, s37
    s_addc_u32 s21, s21, 0
    v_mul_u32_u24 v6, 1280, v1
    v_lshl_add_u32 v18, v2, 4, v6
    v_and_b32 v6, 1, v1
    v_lshrrev_b32 v7, 1, v1
    v_lshl_add_u32 v6, v6, 5, v7
    v_mul_u32_u24 v6, 1280, v6
    v_lshl_add_u32 v19, v2, 4, v6
    v_add_u32 v25, 10240, v19
    v_add_u32 v26, 20480, v19
    v_add_u32 v27, 30720, v19
    s_movk_i32 s37, 24576
    v_lshl_add_u32 v21, v0, 2, s37
    s_lshl_b32 s36, s3, 8
    s_add_u32 s37, s37, s36
    v_lshl_add_u32 v20, v2, 5, s37
    v_and_b32 v6, 16, v0
    v_add_u32 v20, v6, v20
    v_lshrrev_b32 v6, 5, v0
    v_lshl_add_u32 v20, v6, 3, v20
    v_and_b32 v6, 1, v1
    v_lshl_add_u32 v20, v6, 2, v20
    v_lshl_add_u32 v22, v0, 1, s38
    s_lshl_b32 s36, s34, 9
    s_add_u32 s36, s36, 684032
    v_lshl_add_u32 v23, v0, 3, s36
    s_mul_i32 s62, s34, 2944
    s_add_u32 s62, s62, 692224
    s_mov_b32 s40, 0
    s_mov_b32 s41, 0x40480000
L_spin_17:
    ds_read_b64 v[6:7], v5 offset:27416
    s_waitcnt lgkmcnt(0)
    v_readfirstlane_b32 s36, v6
    s_cmp_eq_u32 s36, 1
    s_cbranch_scc1 L_done_18
    s_sleep 2
    s_sub_u32 s35, s35, 1
    s_cbranch_scc0 L_spin_17
    s_branch L_end
L_pad6:
    s_branch L_padret6
L_done_18:
    v_mov_b32 v24, v7
    s_lshl_b32 s36, s3, 5
    v_lshl_add_u32 v6, v1, 2, s36
    ds_read_b32 v12, v6 offset:27008
    s_setprio 3
    s_waitcnt lgkmcnt(0)
    v_and_b32 v44, v12, v8
    v_and_b32 v45, v12, v9
    v_and_b32 v46, v12, v10
    v_and_b32 v47, v12, v11
    s_cmp_lt_u32 s3, 5
    s_cbranch_scc1 L_nothold
    s_call_b64 s[76:77], L_mlpoll
    s_movk_i32 s58, 640
    s_call_b64 s[76:77], L_gate
    global_load_dwordx4 v[28:31], v16, s[28:29] sc1
    global_load_dwordx4 v[92:95], v18, s[20:21] nt
    global_load_dwordx4 v[76:79], v19, s[12:13] nt
    global_load_dwordx4 v[80:83], v25, s[12:13] nt
    global_load_dwordx4 v[84:87], v26, s[12:13] nt
    global_load_dwordx4 v[88:91], v27, s[12:13] nt
    s_waitcnt vmcnt(5)
    s_branch L_ochk
L_nothold:
    s_mul_i32 s58, s3, 4
    s_addk_i32 s58, 389
    s_call_b64 s[76:77], L_gate
    global_load_dwordx4 v[92:95], v18, s[20:21] nt
    global_load_dwordx4 v[76:79], v19, s[12:13] nt
    global_load_dwordx4 v[80:83], v25, s[12:13] nt
    global_load_dwordx4 v[84:87], v26, s[12:13] nt
    global_load_dwordx4 v[88:91], v27, s[12:13] nt
    global_load_dwordx2 v[32:33], v17, s[28:29] offset:1344 sc1
    s_mov_b32 s75, 6
    s_movk_i32 s58, 616
    s_call_b64 s[76:77], L_pace
    global_load_dwordx4 v[28:31], v16, s[28:29] sc1
    s_waitcnt vmcnt(1)
    s_call_b64 s[76:77], L_scale
    s_branch L_owait
L_opoll:
    s_sub_u32 s35, s35, 16
    s_cbranch_scc1 L_end
    global_load_dwordx4 v[28:31], v16, s[28:29] sc1
L_owait:
    s_waitcnt vmcnt(0)
L_ochk:
    v_pk_mul_f32 v[12:13], v[28:29], v[36:37] op_sel_hi:[1,0]
    v_max3_u32 v6, v28, v29, v30
    v_pk_mul_f32 v[14:15], v[30:31], v[36:37] op_sel_hi:[1,0]
    v_max_u32 v6, v6, v31
    v_cmp_eq_u32 vcc, -1, v6
    v_permlane32_swap_b32 v12, v14
    v_permlane32_swap_b32 v13, v15
    v_pk_add_f32 v[12:13], v[12:13], v[14:15]
    s_cbranch_vccnz L_opoll
    v_mov_b32 v4, 1
    v_permlane16_swap_b32 v12, v13
    v_add_f32 v12, v12, v13
    s_nop 1
    v_add_f32_dpp v12, v12, v12 row_ror:8 row_mask:0xf bank_mask:0xf
    v_cvt_pk_bf16_f32 v12, v12, v12
    s_nop 1
    v_mov_b32_dpp v12, v12 row_shl:4 row_mask:0xf bank_mask:0x6
    s_nop 1
    v_and_b32_dpp v48, v12, v8 quad_perm:[0,0,0,0] row_mask:0xf bank_mask:0xf
    v_and_b32_dpp v49, v12, v9 quad_perm:[0,0,0,0] row_mask:0xf bank_mask:0xf
    v_and_b32_dpp v50, v12, v10 quad_perm:[0,0,0,0] row_mask:0xf bank_mask:0xf
    v_and_b32_dpp v51, v12, v11 quad_perm:[0,0,0,0] row_mask:0xf bank_mask:0xf
    s_waitcnt vmcnt(4)
    v_mfma_f32_16x16x32_bf16 v[40:43], v[44:47], v[92:95], 0
    v_and_b32_dpp v52, v12, v8 quad_perm:[1,1,1,1] row_mask:0xf bank_mask:0xf
    v_and_b32_dpp v53, v12, v9 quad_perm:[1,1,1,1] row_mask:0xf bank_mask:0xf
    v_and_b32_dpp v54, v12, v10 quad_perm:[1,1,1,1] row_mask:0xf bank_mask:0xf
    v_and_b32_dpp v55, v12, v11 quad_perm:[1,1,1,1] row_mask:0xf bank_mask:0xf
    s_waitcnt vmcnt(3)
    v_mfma_f32_16x16x32_bf16 v[40:43], v[48:51], v[76:79], v[40:43]
    v_and_b32_dpp v56, v12, v8 quad_perm:[2,2,2,2] row_mask:0xf bank_mask:0xf
    v_and_b32_dpp v57, v12, v9 quad_perm:[2,2,2,2] row_mask:0xf bank_mask:0xf
    v_and_b32_dpp v58, v12, v10 quad_perm:[2,2,2,2] row_mask:0xf bank_mask:0xf
    v_and_b32_dpp v59, v12, v11 quad_perm:[2,2,2,2] row_mask:0xf bank_mask:0xf
    s_waitcnt vmcnt(2)
    v_mfma_f32_16x16x32_bf16 v[40:43], v[52:55], v[80:83], v[40:43]
    v_and_b32_dpp v60, v12, v8 quad_perm:[3,3,3,3] row_mask:0xf bank_mask:0xf
    v_and_b32_dpp v61, v12, v9 quad_perm:[3,3,3,3] row_mask:0xf bank_mask:0xf
    v_and_b32_dpp v62, v12, v10 quad_perm:[3,3,3,3] row_mask:0xf bank_mask:0xf
    v_and_b32_dpp v63, v12, v11 quad_perm:[3,3,3,3] row_mask:0xf bank_mask:0xf
    s_waitcnt vmcnt(1)
    v_mfma_f32_16x16x32_bf16 v[40:43], v[56:59], v[84:87], v[40:43]
    s_waitcnt vmcnt(0)
    v_mfma_f32_16x16x32_bf16 v[40:43], v[60:63], v[88:91], v[40:43]
    s_nop 7
    v_permlane32_swap_b32 v40, v42
    v_permlane32_swap_b32 v41, v43
    s_nop 0
    v_add_f32_dpp v40, v42, v40 row_ror:8 row_mask:0xf bank_mask:0xf
    s_nop 1
    v_add_f32_dpp v40, v41, v43 row_ror:8 row_mask:0xf bank_mask:0xc
    ds_write_b32 v20, v40
    s_mov_b64 exec, 1
    ds_add_rtn_u32 v6, v5, v4 offset:27404
    s_mov_b64 exec, -1
    ds_read2st64_b32 v[64:65], v21 offset0:0 offset1:1
    ds_read2st64_b32 v[66:67], v21 offset0:2 offset1:3
    ds_read2st64_b32 v[68:69], v21 offset0:4 offset1:5
    ds_read2st64_b32 v[70:71], v21 offset0:6 offset1:7
    s_waitcnt lgkmcnt(2)
    v_readfirstlane_b32 s36, v6
    v_pk_add_f32 v[64:65], v[64:65], v[66:67]
    s_cmp_eq_u32 s36, 7
    s_cbranch_scc0 L_end
    s_waitcnt lgkmcnt(0)
    v_pk_add_f32 v[68:69], v[68:69], v[70:71]
    v_pk_add_f32 v[64:65], v[64:65], v[68:69]
    v_add_f32 v64, v64, v65
    v_cvt_f64_f32 v[68:69], v64
    v_cmp_ngt_f32 s[42:43], 0.5, abs(v64)
    v_add_f64 v[66:67], v[68:69], s[40:41]
    v_add_f64 v[70:71], v[66:67], -s[40:41]
    v_add_u32 v67, 0xbff80000, v67
    v_cmp_neq_f64 vcc, v[68:69], v[70:71]
    s_or_b64 vcc, vcc, s[42:43]
    s_cbranch_scc1 L_side
L_acc:
    global_atomic_add_x2 v[68:69], v23, v[66:67], s[28:29] sc0
    v_add_co_u32 v64, vcc, 1, v66
    v_mov_b32 v6, 0x3a480000
    s_nop 0
    v_addc_co_u32 v65, vcc, v6, v67, vcc
    s_waitcnt vmcnt(0)
    v_lshl_add_u64 v[64:65], v[64:65], 0, v[68:69]
    v_add_f64 v[66:67], v[64:65], -s[40:41]
    v_add_u32 v6, 0xbfd80000, v65
    v_cvt_f32_f64 v7, v[66:67]
    v_cmp_gt_u32 vcc, 0x400000, v6
    v_cvt_pk_bf16_f32 v7, v7, v7
    s_and_b64 exec, exec, vcc
    s_cbranch_execz L_nofast
    global_store_short v22, v7, s[24:25]
L_nofast:
    s_not_b64 exec, vcc
    v_bfe_u32 v7, v6, 22, 5
    v_cmp_eq_u32 vcc, 0, v7
    s_and_b64 exec, exec, vcc
    s_cbranch_execz L_end
    v_lshl_add_u32 v14, v0, 2, s62
    global_atomic_or v12, v14, v5, s[28:29] sc0
    v_and_b32 v6, 0xf8000000, v6
    v_sub_u32 v65, v65, v6
    v_add_f64 v[66:67], v[64:65], -s[40:41]
    s_mul_i32 s37, s34, 6144
    s_add_u32 s37, s37, 622592
    v_cvt_f32_f64 v13, v[66:67]
    v_lshl_add_u32 v15, v0, 2, s37
    s_mov_b32 s36, 2
L_sround:
    global_load_dword v28, v15, s[28:29] offset:0 sc1
    global_load_dword v29, v15, s[28:29] offset:256 sc1
    global_load_dword v30, v15, s[28:29] offset:512 sc1
    global_load_dword v31, v15, s[28:29] offset:768 sc1
    global_load_dword v32, v15, s[28:29] offset:1024 sc1
    global_load_dword v33, v15, s[28:29] offset:1280 sc1
    global_load_dword v34, v15, s[28:29] offset:1536 sc1
    global_load_dword v35, v15, s[28:29] offset:1792 sc1
    v_add_u32 v15, 2048, v15
    s_waitcnt vmcnt(0)
    v_bfe_i32 v6, v12, 0, 1
    v_bfi_b32 v28, v6, 0, v28
    v_add_f32 v13, v13, v28
    v_bfe_i32 v6, v12, 1, 1
    v_bfi_b32 v29, v6, 0, v29
    v_add_f32 v13, v13, v29
    v_bfe_i32 v6, v12, 2, 1
    v_bfi_b32 v30, v6, 0, v30
    v_add_f32 v13, v13, v30
    v_bfe_i32 v6, v12, 3, 1
    v_bfi_b32 v31, v6, 0, v31
    v_add_f32 v13, v13, v31
    v_bfe_i32 v6, v12, 4, 1
    v_bfi_b32 v32, v6, 0, v32
    v_add_f32 v13, v13, v32
    v_bfe_i32 v6, v12, 5, 1
    v_bfi_b32 v33, v6, 0, v33
    v_add_f32 v13, v13, v33
    v_bfe_i32 v6, v12, 6, 1
    v_bfi_b32 v34, v6, 0, v34
    v_add_f32 v13, v13, v34
    v_bfe_i32 v6, v12, 7, 1
    v_bfi_b32 v35, v6, 0, v35
    v_add_f32 v13, v13, v35
    v_lshrrev_b32 v12, 8, v12
    s_sub_u32 s36, s36, 1
    s_cbranch_scc0 L_sround
    v_cvt_pk_bf16_f32 v13, v13, v13
    global_store_short v22, v13, s[24:25]
    s_branch L_end
L_side:
    s_mov_b64 exec, vcc
    s_mul_i32 s36, s34, 24
    s_add_u32 s36, s36, s33
    s_lshl_b32 s36, s36, 8
    s_add_u32 s36, s36, 622592
    v_lshl_add_u32 v6, v0, 2, s36
    global_store_dword v6, v64, s[28:29] sc1
    s_lshl_b32 s36, 1, s33
    s_not_b32 s36, s36
    v_mov_b32 v7, s36
    v_lshl_add_u32 v14, v0, 2, s62
    global_atomic_and v14, v7, s[28:29]
    s_waitcnt vmcnt(0)
    v_mov_b32 v66, 0
    v_mov_b32 v67, 0x8400000
    s_mov_b64 exec, -1
    s_branch L_acc
L_end:
L_exit:
    s_endpgm
.section .rodata,"a"
.p2align 6
.amdhsa_kernel gated_mix__sliding_block_cached__glu_gated_swiglu__decode_kernel
  .amdhsa_next_free_vgpr 128
  .amdhsa_next_free_sgpr 102
  .amdhsa_accum_offset 128
  .amdhsa_group_segment_fixed_size 0
  .amdhsa_kernarg_size 104
  .amdhsa_user_sgpr_count 2
  .amdhsa_user_sgpr_kernarg_segment_ptr 1
  .amdhsa_system_sgpr_workgroup_id_x 1
.end_amdhsa_kernel
```
